```python
import torch

def _softmax(x, axis=-1):
    return torch.softmax(x, dim=axis)
def _gelu(x):
    return torch.nn.functional.gelu(x, approximate="tanh")
def _silu(x):
    return torch.nn.functional.silu(x)
def _sigmoid(x):
    return torch.sigmoid(x)
def _layernorm(x, axis=-1, eps=1e-5):
    m = x.mean(dim=axis, keepdim=True)
    v = x.var(dim=axis, keepdim=True, unbiased=False)
    return (x - m) / torch.sqrt(v + eps)
def _scatter_add(tgt, idx, src, axis=0):
    return tgt.clone().index_add_(axis, idx, src)
def _segment_sum(src, seg, n):
    out = torch.zeros((n,) + src.shape[1:], dtype=src.dtype)
    return out.index_add_(0, seg, src)
def _pad(x, pw):
    flat = tuple(v for pair in reversed(pw) for v in pair)
    return torch.nn.functional.pad(x, flat)

kernel_name = 'concat_heads__sliding_block_cached__gqa_block_cached__decode'

def setup_inputs():

    _w = (lambda a: (lambda t: t.to(torch.bfloat16) if t.is_floating_point() else t)(torch.as_tensor(a)))
    def _A_setup():
        B, Sq, D = 4, 1, 1024
        Hq, Hkv, Sk, Dh = 32, 4, 8192, 128
        assert Hq % Hkv == 0, (Hq, Hkv)
        return {
            "x": _w((lambda *s: torch.randn(*s, dtype=torch.bfloat16) * 0.8)(B, Sq, D)),
            "k_cache": _w((lambda *s: torch.randn(*s, dtype=torch.bfloat16) * 1.6)(B, Hkv, Sk, Dh)),
            "v_cache": _w((lambda *s: torch.randn(*s, dtype=torch.bfloat16) * 0.2)(B, Hkv, Sk, Dh)),
            "wq": _w((lambda *s: torch.randn(*s, dtype=torch.bfloat16) * 1.6)(D, Hq * Dh) * (D ** -0.5)),
            "wo": _w((lambda *s: torch.randn(*s, dtype=torch.bfloat16) * 0.2)(Hq * Dh, D) * ((Hq * Dh) ** -0.5)),
        }
    _A_in = _A_setup()

    def _B_setup():
        B, Sq, D = 4, 1, 1024
        Hq, Hkv, Sk, Dh = 32, 4, 8192, 128
        assert Hq % Hkv == 0, (Hq, Hkv)
        return {
            "x": _w((lambda *s: torch.randn(*s, dtype=torch.bfloat16) * 0.8)(B, Sq, D)),
            "k_cache": _w((lambda *s: torch.randn(*s, dtype=torch.bfloat16) * 1.6)(B, Hkv, Sk, Dh)),
            "v_cache": _w((lambda *s: torch.randn(*s, dtype=torch.bfloat16) * 0.2)(B, Hkv, Sk, Dh)),
            "wq": _w((lambda *s: torch.randn(*s, dtype=torch.bfloat16) * 1.6)(D, Hq * Dh) * (D ** -0.5)),
            "wo": _w((lambda *s: torch.randn(*s, dtype=torch.bfloat16) * 0.2)(Hq * Dh, D) * ((Hq * Dh) ** -0.5)),
        }
    _B_in = _B_setup()

    return {
        "A_x": _A_in["x"],
        "A_k_cache": _A_in["k_cache"],
        "A_v_cache": _A_in["v_cache"],
        "A_wq": _A_in["wq"],
        "A_wo": _A_in["wo"],
        "B_x": _B_in["x"],
        "B_k_cache": _B_in["k_cache"],
        "B_v_cache": _B_in["v_cache"],
        "B_wq": _B_in["wq"],
        "B_wo": _B_in["wo"],
    }

def reference(A_x, A_k_cache, A_v_cache, A_wq, A_wo, B_x, B_k_cache, B_v_cache, B_wq, B_wo):
    def _A_ref(x, k_cache, v_cache, wq, wo):
        B, Sq, D = x.shape
        Hq, Dh = 32, 128
        Hkv, Sk = k_cache.shape[1], k_cache.shape[2]
        W = min(4096, max(256, Sk // 4))
        rep = Hq // Hkv
        q = (lambda x, *d: x.permute(*d))((x @ wq).reshape(B, Sq, Hq, Dh), 0, 2, 1, 3)
        k = (lambda x, n, axis: torch.repeat_interleave(x, n, dim=axis))(k_cache[:, :, Sk - W:, :], rep, axis=1)
        v = (lambda x, n, axis: torch.repeat_interleave(x, n, dim=axis))(v_cache[:, :, Sk - W:, :], rep, axis=1)
        scores = torch.einsum("bhqd,bhkd->bhqk", q, k) * (Dh ** -0.5)
        p = _softmax(scores, axis=-1)
        o = torch.einsum("bhqk,bhkd->bhqd", p, v)
        return (lambda x, *d: x.permute(*d))(o, 0, 2, 1, 3).reshape(B, Sq, Hq * Dh) @ wo

    def _B_ref(x, k_cache, v_cache, wq, wo):
        B, Sq, D = x.shape
        Hq, Dh = 32, 128
        Hkv = k_cache.shape[1]
        rep = Hq // Hkv
        q = (lambda x, *d: x.permute(*d))((x @ wq).reshape(B, Sq, Hq, Dh), 0, 2, 1, 3)
        k = (lambda x, n, axis: torch.repeat_interleave(x, n, dim=axis))(k_cache, rep, axis=1)
        v = (lambda x, n, axis: torch.repeat_interleave(x, n, dim=axis))(v_cache, rep, axis=1)
        scores = torch.einsum("bhqd,bhkd->bhqk", q, k) * (Dh ** -0.5)
        p = _softmax(scores, axis=-1)
        o = torch.einsum("bhqk,bhkd->bhqd", p, v)
        return (lambda x, *d: x.permute(*d))(o, 0, 2, 1, 3).reshape(B, Sq, Hq * Dh) @ wo

    a = _A_ref(A_x, A_k_cache, A_v_cache, A_wq, A_wo)
    b = _B_ref(B_x, B_k_cache, B_v_cache, B_wq, B_wo)
    return torch.concatenate([a, b], axis=-1)
```

```asm
; @launch grid=(256,1,1) block=(576,1,1) lds=152448
.amdgcn_target "amdgcn-amd-amdhsa--gfx950"
.text
.globl concat_heads__sliding_block_cached__gqa_block_cached__decode_kernel
.p2align 8
.type concat_heads__sliding_block_cached__gqa_block_cached__decode_kernel,@function
concat_heads__sliding_block_cached__gqa_block_cached__decode_kernel:
    s_cmp_ge_u32 s2, 256
    s_cbranch_scc1 L_end
    s_load_dwordx16 s[4:19], s[0:1], 0
    s_load_dwordx8 s[20:27], s[0:1], 64
    s_load_dwordx2 s[28:29], s[0:1], 96
    v_lshrrev_b32 v1, 6, v0
    v_and_b32 v0, 63, v0
    s_and_b32 s31, s2, 1
    v_readfirstlane_b32 s3, v1
    s_lshl_b32 s31, s31, 5
    s_lshr_b32 s30, s2, 3
    s_add_u32 s31, s31, s30
    s_xor_b32 s31, s31, 0
    s_bfe_u32 s30, s2, 0x20001
    s_lshr_b32 s32, s2, 5
    v_mov_b32 v1, 152320
    s_mov_b32 s97, 0x400000
    s_sub_u32 s3, s3, 1
    s_cbranch_scc0 L_C
    s_setprio 3
    s_mul_i32 s33, s2, 2
    s_mul_i32 s54, s31, 5
    s_add_u32 s33, s33, s54
    s_lshl_b32 s54, s33, 1
    v_add_u32 v8, s54, v0
    v_and_b32 v8, 31, v8
    v_lshlrev_b32 v8, 4, v8
    v_lshrrev_b32 v4, 4, v0
    v_and_b32 v5, 15, v0
    v_lshlrev_b32 v6, 1, v4
    v_xor_b32 v6, v6, v5
    v_lshlrev_b32 v7, 13, v4
    v_lshl_add_u32 v10, v6, 4, v7
    v_xor_b32 v11, 0x80, v10
    v_add_u32 v12, 63488, v10
    v_add_u32 v13, 95232, v11
    v_add_u32 v11, 31744, v11
    s_bfe_u32 s54, s31, 0x20003
    s_lshl_b32 s53, s54, 9
    s_lshl_b32 s52, s54, 21
    s_lshl_b32 s54, s30, 11
    s_add_u32 s52, s52, s54
    s_and_b32 s54, s31, 7
    s_lshl_b32 s54, s54, 8
    s_add_u32 s52, s52, s54
    s_waitcnt lgkmcnt(0)
    s_cmp_ge_u32 s31, 32
    s_cselect_b32 s56, s20, s10
    s_cselect_b32 s57, s21, s11
    s_cselect_b32 s58, s14, s4
    s_cselect_b32 s59, s15, s5
    s_cselect_b32 s12, s22, s12
    s_cselect_b32 s13, s23, s13
    s_mov_b32 s44, s58
    s_mov_b32 s45, s59
    s_mov_b32 s46, 8192
    s_mov_b32 s47, 0x20000
    s_mov_b32 s36, s56
    s_mov_b32 s37, s57
    s_mov_b32 s38, 8388608
    s_mov_b32 s39, 0x20000
    s_mov_b32 m0, 131072
    s_add_u32 s54, s53, 0
    buffer_load_dwordx4 v8, s[44:47], s54 offen lds
    s_mov_b32 m0, 132160
    s_add_u32 s54, s53, 2048
    buffer_load_dwordx4 v8, s[44:47], s54 offen lds
    s_mov_b32 m0, 133248
    s_add_u32 s54, s53, 4096
    buffer_load_dwordx4 v8, s[44:47], s54 offen lds
    s_mov_b32 m0, 134336
    s_add_u32 s54, s53, 6144
    buffer_load_dwordx4 v8, s[44:47], s54 offen lds
    s_mov_b32 s50, 0
    s_mov_b32 s51, s33
    s_mov_b32 s68, 0
L_pro1:
    s_and_b32 s55, s50, 31
    s_lshl_b32 m0, s55, 12
    s_and_b32 s55, s51, 15
    s_lshl_b32 s55, s55, 17
    s_add_u32 s55, s55, s52
    buffer_load_dwordx4 v10, s[36:39], s55 offen offset:0 nt lds
    buffer_load_dwordx4 v11, s[36:39], s55 offen offset:1024 nt lds
    buffer_load_dwordx4 v12, s[36:39], s55 offen offset:2048 nt lds
    buffer_load_dwordx4 v13, s[36:39], s55 offen offset:3072 nt lds
    s_add_u32 s50, s50, 1
    s_add_u32 s51, s51, 1
    s_cmp_lt_u32 s50, 6
    s_cbranch_scc1 L_pro1
    s_mul_i32 s69, s2, 0
    s_lshr_b32 s69, s69, 0
    s_and_b32 s69, s69, 30
    s_or_b32 s69, s69, 1
    v_lshrrev_b32 v4, 4, v0
    v_and_b32 v5, 15, v0
    v_xor_b32 v6, v4, v5
    v_lshlrev_b32 v7, 8, v4
    v_lshl_add_u32 v14, v6, 4, v7
    v_xor_b32 v15, 64, v14
    v_xor_b32 v16, 0x80, v14
    v_xor_b32 v17, 0xc0, v14
    v_lshlrev_b32 v6, 1, v4
    v_xor_b32 v6, v6, v5
    v_lshl_add_u32 v18, v6, 4, v7
    v_xor_b32 v19, 0x80, v18
    v_lshrrev_b32 v4, 5, v0
    v_and_b32 v5, 31, v0
    v_lshlrev_b32 v6, 1, v4
    v_xor_b32 v6, v6, v5
    v_lshlrev_b32 v7, 11, v4
    v_lshl_add_u32 v22, v6, 4, v7
    v_xor_b32 v23, 64, v22
    v_add_u32 v24, 260096, v22
    v_add_u32 v25, 263168, v23
    v_add_u32 v23, 3072, v23
    v_and_b32 v2, 7, v0
    v_lshlrev_b32 v2, 2, v2
    v_add_u32 v2, 152352, v2
    s_lshr_b32 s54, s31, 4
    s_lshl_b32 s54, s54, 2
    s_add_u32 s54, s54, s30
    s_lshl_b32 s66, s54, 21
    s_and_b32 s54, s31, 15
    s_mul_i32 s55, s54, 163840
    s_add_u32 s66, s66, s55
    s_sub_u32 s66, s66, 524288
    s_cmp_le_u32 s54, 2
    s_cselect_b32 s4, s6, s16
    s_cselect_b32 s5, s7, s17
    s_cselect_b32 s10, s8, s18
    s_cselect_b32 s11, s9, s19
    s_cselect_b32 s55, 2097152, 0
    s_add_u32 s55, s55, 32768
    s_cmp_le_u32 s54, 3
    s_cselect_b32 s6, s6, s16
    s_cselect_b32 s7, s7, s17
    s_cselect_b32 s8, s8, s18
    s_cselect_b32 s9, s9, s19
    s_cselect_b32 s65, 2097152, 0
    s_add_u32 s65, s65, s66
    s_add_u32 s66, s66, s55
    s_lshl_b32 s67, s30, 21
    s_bfe_u32 s54, s31, 0x30002
    s_lshl_b32 s54, s54, 15
    s_add_u32 s67, s67, s54
    s_and_b32 s54, s31, 3
    s_lshl_b32 s54, s54, 9
    s_add_u32 s67, s67, s54
    s_barrier
L_ld2:
    s_sub_u32 s54, s50, 5
    s_max_i32 s68, s68, s54
    v_mov_b32 v21, s68
    s_and_b32 s55, s50, 31
    s_lshl_b32 m0, s55, 12
    s_and_b32 s55, s51, 15
    s_lshl_b32 s55, s55, 17
    s_add_u32 s55, s55, s52
    s_waitcnt vmcnt(20)
    ds_write_b32 v1, v21
    buffer_load_dwordx4 v10, s[36:39], s55 offen offset:0 nt lds
    s_waitcnt vmcnt(20)
    buffer_load_dwordx4 v11, s[36:39], s55 offen offset:1024 nt lds
    s_waitcnt vmcnt(20)
    buffer_load_dwordx4 v12, s[36:39], s55 offen offset:2048 nt lds
    s_waitcnt vmcnt(20)
    buffer_load_dwordx4 v13, s[36:39], s55 offen offset:3072 nt lds
    s_add_u32 s50, s50, 1
    s_add_u32 s51, s51, 1
    s_cmp_lt_u32 s50, 16
    s_cbranch_scc1 L_ld2
    s_mov_b32 s36, s6
    s_mov_b32 s37, s7
    s_mov_b32 s38, 33554432
    s_mov_b32 s39, 0x20000
    s_mov_b32 s52, s65
    s_mov_b32 s51, s33
L_ld5:
    s_sub_u32 s54, s50, 5
    s_max_i32 s68, s68, s54
    v_mov_b32 v21, s68
    s_and_b32 s55, s50, 31
    s_lshl_b32 m0, s55, 12
    s_and_b32 s55, s51, 7
    s_lshl_b32 s55, s55, 12
    s_add_u32 s55, s55, s52
    s_waitcnt vmcnt(20)
    ds_write_b32 v1, v21
    buffer_load_dwordx4 v14, s[36:39], s55 offen offset:0 nt lds
    s_waitcnt vmcnt(20)
    buffer_load_dwordx4 v15, s[36:39], s55 offen offset:1024 nt lds
    s_waitcnt vmcnt(20)
    buffer_load_dwordx4 v16, s[36:39], s55 offen offset:2048 nt lds
    s_waitcnt vmcnt(20)
    buffer_load_dwordx4 v17, s[36:39], s55 offen offset:3072 nt lds
    s_add_u32 s50, s50, 1
    s_add_u32 s51, s51, s69
    s_cmp_lt_u32 s50, 24
    s_cbranch_scc1 L_ld5
    s_mov_b32 s36, s4
    s_mov_b32 s37, s5
    s_mov_b32 s38, 33554432
    s_mov_b32 s39, 0x20000
    s_mov_b32 s52, s66
    s_mov_b32 s51, s33
    ds_read_b32 v20, v2
L_ld8:
    s_sub_i32 s54, s50, 31
L_fc9:
    s_waitcnt lgkmcnt(0)
    v_cmp_gt_i32 vcc, s54, v20
    s_nop 1
    s_cmp_eq_u64 vcc, 0
    s_cbranch_scc1 L_go10
    s_sub_u32 s97, s97, 1
    s_cbranch_scc1 L_dead
    s_add_u32 s64, s64, 1
    ds_read_b32 v20, v2
    s_branch L_fc9
L_go10:
    s_sub_u32 s54, s50, 5
    s_max_i32 s68, s68, s54
    v_mov_b32 v21, s68
    s_and_b32 s55, s50, 31
    s_lshl_b32 m0, s55, 12
    s_and_b32 s55, s51, 31
    s_lshl_b32 s55, s55, 12
    s_add_u32 s55, s55, s52
    s_waitcnt vmcnt(20)
    ds_write_b32 v1, v21
    buffer_load_dwordx4 v14, s[36:39], s55 offen offset:0 nt lds
    s_waitcnt vmcnt(20)
    buffer_load_dwordx4 v15, s[36:39], s55 offen offset:1024 nt lds
    s_waitcnt vmcnt(20)
    ds_read_b32 v20, v2
    buffer_load_dwordx4 v16, s[36:39], s55 offen offset:2048 nt lds
    s_waitcnt vmcnt(20)
    buffer_load_dwordx4 v17, s[36:39], s55 offen offset:3072 nt lds
    s_add_u32 s50, s50, 1
    s_add_u32 s51, s51, s69
    s_cmp_lt_u32 s50, 56
    s_cbranch_scc1 L_ld8
    s_mov_b32 s36, s8
    s_mov_b32 s37, s9
    s_mov_b32 s38, 33554432
    s_mov_b32 s39, 0x20000
    s_mov_b32 s52, s65
    s_mov_b32 s51, s33
L_ld11:
    s_sub_i32 s54, s50, 31
L_fc12:
    s_waitcnt lgkmcnt(0)
    v_cmp_gt_i32 vcc, s54, v20
    s_nop 1
    s_cmp_eq_u64 vcc, 0
    s_cbranch_scc1 L_go13
    s_sub_u32 s97, s97, 1
    s_cbranch_scc1 L_dead
    s_add_u32 s64, s64, 1
    ds_read_b32 v20, v2
    s_branch L_fc12
L_go13:
    s_sub_u32 s54, s50, 5
    s_max_i32 s68, s68, s54
    v_mov_b32 v21, s68
    s_and_b32 s55, s50, 31
    s_lshl_b32 m0, s55, 12
    s_and_b32 s55, s51, 7
    s_lshl_b32 s55, s55, 12
    s_add_u32 s55, s55, s52
    s_waitcnt vmcnt(20)
    ds_write_b32 v1, v21
    buffer_load_dwordx4 v18, s[36:39], s55 offen offset:0 nt lds
    s_waitcnt vmcnt(20)
    buffer_load_dwordx4 v19, s[36:39], s55 offen offset:1024 nt lds
    s_waitcnt vmcnt(20)
    ds_read_b32 v20, v2
    buffer_load_dwordx4 v18, s[36:39], s55 offen offset:2048 nt lds
    s_waitcnt vmcnt(20)
    buffer_load_dwordx4 v19, s[36:39], s55 offen offset:3072 nt lds
    s_add_u32 s50, s50, 1
    s_add_u32 s51, s51, s69
    s_cmp_lt_u32 s50, 64
    s_cbranch_scc1 L_ld11
    s_mov_b32 s36, s10
    s_mov_b32 s37, s11
    s_mov_b32 s38, 33554432
    s_mov_b32 s39, 0x20000
    s_mov_b32 s52, s66
    s_mov_b32 s51, s33
L_ld14:
    s_sub_i32 s54, s50, 31
L_fc15:
    s_waitcnt lgkmcnt(0)
    v_cmp_gt_i32 vcc, s54, v20
    s_nop 1
    s_cmp_eq_u64 vcc, 0
    s_cbranch_scc1 L_go16
    s_sub_u32 s97, s97, 1
    s_cbranch_scc1 L_dead
    s_add_u32 s64, s64, 1
    ds_read_b32 v20, v2
    s_branch L_fc15
L_go16:
    s_sub_u32 s54, s50, 5
    s_max_i32 s68, s68, s54
    v_mov_b32 v21, s68
    s_and_b32 s55, s50, 31
    s_lshl_b32 m0, s55, 12
    s_and_b32 s55, s51, 31
    s_lshl_b32 s55, s55, 12
    s_add_u32 s55, s55, s52
    s_waitcnt vmcnt(20)
    ds_write_b32 v1, v21
    buffer_load_dwordx4 v18, s[36:39], s55 offen offset:0 nt lds
    s_waitcnt vmcnt(20)
    buffer_load_dwordx4 v19, s[36:39], s55 offen offset:1024 nt lds
    s_waitcnt vmcnt(20)
    ds_read_b32 v20, v2
    buffer_load_dwordx4 v18, s[36:39], s55 offen offset:2048 nt lds
    s_waitcnt vmcnt(20)
    buffer_load_dwordx4 v19, s[36:39], s55 offen offset:3072 nt lds
    s_add_u32 s50, s50, 1
    s_add_u32 s51, s51, s69
    s_cmp_lt_u32 s50, 96
    s_cbranch_scc1 L_ld14
    s_mov_b32 s36, s12
    s_mov_b32 s37, s13
    s_mov_b32 s38, 8388608
    s_mov_b32 s39, 0x20000
    s_mov_b32 s52, s67
    s_mul_i32 s51, s2, 1
L_ld17:
    s_mov_b32 s54, 80
L_fc18:
    s_waitcnt lgkmcnt(0)
    v_cmp_gt_i32 vcc, s54, v20
    s_nop 1
    s_cmp_eq_u64 vcc, 0
    s_cbranch_scc1 L_go19
    s_sub_u32 s97, s97, 1
    s_cbranch_scc1 L_dead
    s_add_u32 s64, s64, 1
    ds_read_b32 v20, v2
    s_branch L_fc18
L_go19:
    s_sub_u32 s54, s50, 4
    s_max_i32 s68, s68, s54
    v_mov_b32 v21, s68
    s_and_b32 s51, s51, 3
    s_and_b32 s55, s50, 12
    s_add_u32 s55, s55, s51
    s_lshl_b32 m0, s55, 12
    s_and_b32 s55, s51, 1
    s_lshl_b32 s55, s55, 7
    v_xor_b32 v26, s55, v22
    v_xor_b32 v27, s55, v23
    v_xor_b32 v28, s55, v24
    v_xor_b32 v29, s55, v25
    s_lshr_b32 s55, s50, 2
    s_add_u32 s55, s55, s32
    s_and_b32 s55, s55, 3
    s_lshl_b32 s55, s55, 13
    s_lshl_b32 s54, s51, 19
    s_add_u32 s55, s55, s54
    s_add_u32 s55, s55, s52
    s_waitcnt vmcnt(17)
    buffer_load_dwordx4 v26, s[36:39], s55 offen offset:0 nt lds
    s_waitcnt vmcnt(17)
    ds_write_b32 v1, v21
    buffer_load_dwordx4 v27, s[36:39], s55 offen offset:1024 nt lds
    s_waitcnt vmcnt(17)
    ds_read_b32 v20, v2
    buffer_load_dwordx4 v28, s[36:39], s55 offen offset:2048 nt lds
    s_waitcnt vmcnt(17)
    buffer_load_dwordx4 v29, s[36:39], s55 offen offset:3072 nt lds
    s_add_u32 s50, s50, 1
    s_add_u32 s51, s51, 1
    s_cmp_lt_u32 s50, 112
    s_cbranch_scc1 L_ld17
    s_waitcnt vmcnt(0)
    s_barrier
    s_branch L_fin
L_C:
    s_lshl_b32 s54, s3, 2
    s_add_u32 s54, s54, 152352
    v_mov_b32 v2, s54
    v_mov_b32 v3, 0
    ds_write_b32 v2, v3
    v_mov_b32 v4, 0
    v_mov_b32 v5, 0
    ds_write_b64 v1, v[4:5]
    v_mov_b32 v166, 0xff
    s_mov_b32 s40, 0
    v_lshrrev_b32 v4, 2, v0
    v_and_b32 v6, 7, v4
    v_xor_b32 v6, s3, v6
    v_lshlrev_b32 v144, 8, v4
    v_lshl_add_u32 v144, v6, 5, v144
    v_and_b32 v6, 3, v0
    v_lshl_add_u32 v144, v6, 3, v144
    v_add_u32 v145, 0x10000, v144
    s_waitcnt lgkmcnt(0)
    s_load_dword s34, s[28:29], 0
    s_cmp_lg_u32 s3, 7
    s_cbranch_scc1 L_ntl
    s_mov_b64 exec, 1
    s_and_b32 s39, s31, 15
    s_lshr_b32 s54, s31, 4
    s_lshl_b32 s54, s54, 2
    s_add_u32 s54, s54, s30
    s_lshl_b32 s54, s54, 21
    s_mul_i32 s55, s39, 163840
    s_sub_i32 s56, s55, 524288
    s_max_i32 s56, s56, 0
    s_add_u32 s56, s56, s54
    s_add_u32 s55, s55, s54
    s_add_u32 s55, s55, 1572864
    s_mov_b64 exec, 0x1
    v_lshlrev_b32 v10, 21, v0
    v_min_u32 v10, 163712, v10
    v_add_u32 v8, s55, v10
    v_add_u32 v9, s56, v10
    v_min_u32 v8, 33554304, v8
    s_cmp_gt_u32 s39, 3
    s_cbranch_scc1 L_ntA
    global_load_dword v12, v8, s[6:7] nt
    global_load_dword v13, v8, s[8:9] nt
L_ntA:
    s_cmp_lt_u32 s39, 3
    s_cbranch_scc1 L_ntB
    global_load_dword v14, v9, s[16:17] nt
    global_load_dword v15, v9, s[18:19] nt
L_ntB:
    s_lshl_b32 s54, s30, 21
    s_bfe_u32 s55, s31, 0x30002
    s_lshl_b32 s55, s55, 15
    s_add_u32 s54, s54, s55
    s_mov_b64 exec, 1
    v_lshlrev_b32 v10, 18, v0
    v_add_u32 v10, s54, v10
    s_cmp_ge_u32 s31, 32
    s_cselect_b32 s54, s22, s12
    s_cselect_b32 s55, s23, s13
    global_load_dword v16, v10, s[54:55]
    s_mov_b64 exec, 1
    v_mov_b32 v11, 0x380000
    v_mov_b32 v17, 0x580000
    v_mov_b32 v18, 0
    global_load_dword v19, v11, s[28:29]
    global_load_dword v20, v17, s[28:29]
    s_mov_b64 exec, -1
L_ntl:
    s_mov_b32 s60, s28
    s_mov_b32 s61, s29
    s_mov_b32 s62, 268435456
    s_mov_b32 s63, 0x20000
    s_and_b32 s39, s31, 15
    v_mov_b32 v146, 0
    s_mov_b32 s96, 0
    s_mov_b32 s36, 0x0c0c0400
    s_waitcnt lgkmcnt(0)
    s_barrier
    s_waitcnt lgkmcnt(0)
    s_add_u32 s34, s34, 0x01010101
    s_and_b32 s35, s34, 0xff
    s_bfe_u32 s4, s34, 0x80008
    s_bfe_u32 s5, s34, 0x80010
    s_lshr_b32 s10, s34, 24
    s_mov_b32 s38, s34
    s_and_b32 s37, s34, 0xffff
    s_cmp_ge_u32 s3, 4
    s_cbranch_scc1 L_noq
    v_bfe_u32 v4, v0, 2, 1
    v_and_b32 v5, 1, v0
    v_lshl_add_u32 v5, v4, 1, v5
    v_lshrrev_b32 v6, 4, v0
    v_mul_u32_u24 v7, 1088, v5
    v_lshl_add_u32 v7, v6, 3, v7
    v_add_u32 v7, 131072, v7
    v_bfe_u32 v4, v0, 3, 2
    v_and_b32 v5, 7, v0
    v_mul_u32_u24 v70, 16384, v4
    v_lshl_add_u32 v70, v5, 4, v70
    s_lshl_b32 s54, s3, 1
    s_xor_b32 s54, s54, s3
    s_lshl_b32 s54, s54, 5
    v_xor_b32 v5, s54, v144
    v_xor_b32 v6, 32, v5
    s_lshr_b32 s55, s31, 5
    s_lshl_b32 s55, s55, 2
    s_add_u32 s55, s55, s30
    s_mul_i32 s55, s55, 65536
    s_and_b32 s54, s31, 7
    s_lshl_b32 s54, s54, 11
    s_add_u32 s55, s55, s54
    s_bfe_u32 s54, s31, 0x20003
    s_lshl_b32 s54, s54, 9
    s_add_u32 s55, s55, s54
    s_lshl_b32 s54, s3, 7
    s_add_u32 s55, s55, s54
    s_add_u32 s55, s55, 65536
    s_cmp_ge_u32 s40, 4
    s_cbranch_scc1 L_ok21
L_sp20:
    ds_read_b32 v3, v1 offset:0
    s_waitcnt lgkmcnt(0)
    v_readfirstlane_b32 s40, v3
    s_sub_u32 s97, s97, 1
    s_cbranch_scc1 L_dead
    s_cmp_ge_u32 s40, 4
    s_cbranch_scc1 L_ok21
    s_sleep 1
    s_branch L_sp20
L_ok21:
    ds_read2_b64 v[40:43], v7 offset0:0 offset1:4
    ds_read_b64_tr_b16 v[8:9], v5 offset:0
    ds_read_b64_tr_b16 v[10:11], v5 offset:4096
    ds_read_b64_tr_b16 v[12:13], v6 offset:0
    ds_read_b64_tr_b16 v[14:15], v6 offset:4096
    ds_read2_b64 v[44:47], v7 offset0:8 offset1:12
    ds_read_b64_tr_b16 v[16:17], v5 offset:8192
    ds_read_b64_tr_b16 v[18:19], v5 offset:12288
    ds_read_b64_tr_b16 v[20:21], v6 offset:8192
    ds_read_b64_tr_b16 v[22:23], v6 offset:12288
    s_waitcnt lgkmcnt(5)
    v_mfma_f32_16x16x32_bf16 v[56:59], v[40:43], v[8:11], 0
    v_mfma_f32_16x16x32_bf16 v[60:63], v[40:43], v[12:15], 0
    s_waitcnt lgkmcnt(0)
    v_mfma_f32_16x16x32_bf16 v[56:59], v[44:47], v[16:19], v[56:59]
    v_mfma_f32_16x16x32_bf16 v[60:63], v[44:47], v[20:23], v[60:63]
    s_cmp_ge_u32 s40, 8
    s_cbranch_scc1 L_ok23
L_sp22:
    ds_read_b32 v3, v1 offset:0
    s_waitcnt lgkmcnt(0)
    v_readfirstlane_b32 s40, v3
    s_sub_u32 s97, s97, 1
    s_cbranch_scc1 L_dead
    s_cmp_ge_u32 s40, 8
    s_cbranch_scc1 L_ok23
    s_sleep 1
    s_branch L_sp22
L_ok23:
    ds_read2_b64 v[40:43], v7 offset0:16 offset1:20
    ds_read_b64_tr_b16 v[8:9], v5 offset:16384
    ds_read_b64_tr_b16 v[10:11], v5 offset:20480
    ds_read_b64_tr_b16 v[12:13], v6 offset:16384
    ds_read_b64_tr_b16 v[14:15], v6 offset:20480
    ds_read2_b64 v[44:47], v7 offset0:24 offset1:28
    ds_read_b64_tr_b16 v[16:17], v5 offset:24576
    ds_read_b64_tr_b16 v[18:19], v5 offset:28672
    ds_read_b64_tr_b16 v[20:21], v6 offset:24576
    ds_read_b64_tr_b16 v[22:23], v6 offset:28672
    s_waitcnt lgkmcnt(5)
    v_mfma_f32_16x16x32_bf16 v[56:59], v[40:43], v[8:11], v[56:59]
    v_mfma_f32_16x16x32_bf16 v[60:63], v[40:43], v[12:15], v[60:63]
    s_waitcnt lgkmcnt(0)
    v_mfma_f32_16x16x32_bf16 v[56:59], v[44:47], v[16:19], v[56:59]
    v_mfma_f32_16x16x32_bf16 v[60:63], v[44:47], v[20:23], v[60:63]
    s_cmp_ge_u32 s40, 12
    s_cbranch_scc1 L_ok25
L_sp24:
    ds_read_b32 v3, v1 offset:0
    s_waitcnt lgkmcnt(0)
    v_readfirstlane_b32 s40, v3
    s_sub_u32 s97, s97, 1
    s_cbranch_scc1 L_dead
    s_cmp_ge_u32 s40, 12
    s_cbranch_scc1 L_ok25
    s_sleep 1
    s_branch L_sp24
L_ok25:
    ds_read2_b64 v[40:43], v7 offset0:32 offset1:36
    ds_read_b64_tr_b16 v[8:9], v5 offset:32768
    ds_read_b64_tr_b16 v[10:11], v5 offset:36864
    ds_read_b64_tr_b16 v[12:13], v6 offset:32768
    ds_read_b64_tr_b16 v[14:15], v6 offset:36864
    ds_read2_b64 v[44:47], v7 offset0:40 offset1:44
    ds_read_b64_tr_b16 v[16:17], v5 offset:40960
    ds_read_b64_tr_b16 v[18:19], v5 offset:45056
    ds_read_b64_tr_b16 v[20:21], v6 offset:40960
    ds_read_b64_tr_b16 v[22:23], v6 offset:45056
    s_waitcnt lgkmcnt(5)
    v_mfma_f32_16x16x32_bf16 v[56:59], v[40:43], v[8:11], v[56:59]
    v_mfma_f32_16x16x32_bf16 v[60:63], v[40:43], v[12:15], v[60:63]
    s_waitcnt lgkmcnt(0)
    v_mfma_f32_16x16x32_bf16 v[56:59], v[44:47], v[16:19], v[56:59]
    v_mfma_f32_16x16x32_bf16 v[60:63], v[44:47], v[20:23], v[60:63]
    s_cmp_ge_u32 s40, 16
    s_cbranch_scc1 L_ok27
L_sp26:
    ds_read_b32 v3, v1 offset:0
    s_waitcnt lgkmcnt(0)
    v_readfirstlane_b32 s40, v3
    s_sub_u32 s97, s97, 1
    s_cbranch_scc1 L_dead
    s_cmp_ge_u32 s40, 16
    s_cbranch_scc1 L_ok27
    s_sleep 1
    s_branch L_sp26
L_ok27:
    ds_read2_b64 v[40:43], v7 offset0:48 offset1:52
    ds_read_b64_tr_b16 v[8:9], v5 offset:49152
    ds_read_b64_tr_b16 v[10:11], v5 offset:53248
    ds_read_b64_tr_b16 v[12:13], v6 offset:49152
    ds_read_b64_tr_b16 v[14:15], v6 offset:53248
    ds_read2_b64 v[44:47], v7 offset0:56 offset1:60
    ds_read_b64_tr_b16 v[16:17], v5 offset:57344
    ds_read_b64_tr_b16 v[18:19], v5 offset:61440
    ds_read_b64_tr_b16 v[20:21], v6 offset:57344
    ds_read_b64_tr_b16 v[22:23], v6 offset:61440
    s_waitcnt lgkmcnt(5)
    v_mfma_f32_16x16x32_bf16 v[56:59], v[40:43], v[8:11], v[56:59]
    v_mfma_f32_16x16x32_bf16 v[60:63], v[40:43], v[12:15], v[60:63]
    s_waitcnt lgkmcnt(0)
    v_mfma_f32_16x16x32_bf16 v[56:59], v[44:47], v[16:19], v[56:59]
    v_mfma_f32_16x16x32_bf16 v[60:63], v[44:47], v[20:23], v[60:63]
    s_nop 6
    v_mov_b32_dpp v56, v57 row_ror:8 row_mask:0xf bank_mask:0xc
    v_mov_b32_dpp v59, v58 row_ror:8 row_mask:0xf bank_mask:0x3
    v_mov_b32_dpp v60, v61 row_ror:8 row_mask:0xf bank_mask:0xc
    v_mov_b32_dpp v63, v62 row_ror:8 row_mask:0xf bank_mask:0x3
    s_mov_b32 exec_hi, 0
    v_bfi_b32 v64, v166, s4, v56
    v_bfi_b32 v65, v166, s35, v59
    v_bfi_b32 v66, v166, s10, v60
    v_bfi_b32 v67, v166, s5, v63
    buffer_store_dwordx4 v[64:67], v70, s[60:63], s55 offen sc1 nt
    s_mov_b64 exec, -1
L_noq:
    s_add_u32 s53, s3, 16
    v_mov_b32 v3, s53
    ds_write_b32 v2, v3
    s_cmp_lt_u32 s3, 6
    s_cbranch_scc1 L_ntw
    s_waitcnt vmcnt(0)
L_ntw:
    v_and_b32 v4, 15, v0
    v_lshrrev_b32 v5, 4, v0
    v_xor_b32 v6, v4, v5
    v_lshlrev_b32 v7, 8, v4
    v_lshl_add_u32 v140, v6, 4, v7
    s_lshl_b32 s54, s3, 12
    s_add_u32 s54, s54, 0x10000
    v_add_u32 v140, s54, v140
    v_xor_b32 v141, 64, v140
    v_xor_b32 v142, 0x80, v140
    v_xor_b32 v143, 0xc0, v140
    v_lshrrev_b32 v4, 5, v0
    v_and_b32 v5, 31, v0
    v_lshlrev_b32 v146, 4, v0
    s_lshr_b32 s54, s31, 4
    s_mul_i32 s50, s54, 16384
    s_mul_i32 s54, s30, 65536
    s_add_u32 s50, s50, s54
    s_lshl_b32 s54, s3, 11
    s_add_u32 s50, s50, s54
    s_add_u32 s50, s50, 65536
    s_cmp_le_u32 s39, 2
    s_cselect_b32 s51, 0, 262144
    s_add_u32 s51, s51, s50
    v_mul_u32_u24 v147, 2176, v4
    v_lshrrev_b32 v6, 3, v5
    v_lshl_add_u32 v147, v6, 6, v147
    v_and_b32 v5, 7, v0
    v_lshl_add_u32 v147, v5, 1, v147
    s_mul_i32 s54, s3, 272
    s_add_u32 s54, s54, 135424
    v_add_u32 v147, s54, v147
    v_mov_b32 v158, s4
    v_mov_b32 v159, s35
    v_mov_b32 v160, s10
    v_mov_b32 v161, s5
    v_mov_b32 v162, s4
    v_mov_b32 v163, s35
    v_mov_b32 v164, s10
    v_mov_b32 v165, s5
    s_add_u32 s53, s3, 17
    s_cmp_ge_u32 s40, s53
    s_cbranch_scc1 L_ok29
L_sp28:
    ds_read_b32 v3, v1 offset:0
    s_waitcnt lgkmcnt(0)
    v_readfirstlane_b32 s40, v3
    s_sub_u32 s97, s97, 1
    s_cbranch_scc1 L_dead
    s_cmp_ge_u32 s40, s53
    s_cbranch_scc1 L_ok29
    s_sleep 1
    s_branch L_sp28
L_ok29:
    ds_read_b128 v[8:11], v140 offset:0
    ds_read_b128 v[12:15], v141 offset:0
    ds_read_b128 v[16:19], v142 offset:0
    ds_read_b128 v[20:23], v143 offset:0
    s_add_u32 s53, s53, 7
    s_waitcnt lgkmcnt(0)
    v_mov_b32 v3, s53
    ds_write_b32 v2, v3
    s_add_u32 s53, s3, 25
    s_cmp_ge_u32 s40, s53
    s_cbranch_scc1 L_ok31
L_sp30:
    ds_read_b32 v3, v1 offset:0
    s_waitcnt lgkmcnt(0)
    v_readfirstlane_b32 s40, v3
    s_sub_u32 s97, s97, 1
    s_cbranch_scc1 L_dead
    s_cmp_ge_u32 s40, s53
    s_cbranch_scc1 L_ok31
    s_sleep 1
    s_branch L_sp30
L_ok31:
    ds_read_b128 v[24:27], v140 offset:32768
    ds_read_b128 v[28:31], v141 offset:32768
    ds_read_b128 v[32:35], v142 offset:32768
    ds_read_b128 v[36:39], v143 offset:32768
    s_add_u32 s53, s53, 7
    s_waitcnt lgkmcnt(0)
    v_mov_b32 v3, s53
    ds_write_b32 v2, v3
    s_add_u32 s53, s3, 33
    s_cmp_ge_u32 s40, s53
    s_cbranch_scc1 L_ok33
L_sp32:
    ds_read_b32 v3, v1 offset:0
    s_waitcnt lgkmcnt(0)
    v_readfirstlane_b32 s40, v3
    s_sub_u32 s97, s97, 1
    s_cbranch_scc1 L_dead
    s_cmp_ge_u32 s40, s53
    s_cbranch_scc1 L_ok33
    s_sleep 1
    s_branch L_sp32
L_ok33:
    v_xor_b32 v140, 0x10000, v140
    v_xor_b32 v141, 0x10000, v141
    v_xor_b32 v142, 0x10000, v142
    v_xor_b32 v143, 0x10000, v143
    ds_read_b128 v[40:43], v140 offset:0
    ds_read_b128 v[44:47], v141 offset:0
    ds_read_b128 v[48:51], v142 offset:0
    ds_read_b128 v[52:55], v143 offset:0
    s_add_u32 s53, s53, 7
    s_waitcnt lgkmcnt(0)
    v_mov_b32 v3, s53
    ds_write_b32 v2, v3
    s_add_u32 s53, s3, 41
    s_cmp_ge_u32 s40, s53
    s_cbranch_scc1 L_ok35
L_sp34:
    ds_read_b32 v3, v1 offset:0
    s_waitcnt lgkmcnt(0)
    v_readfirstlane_b32 s40, v3
    s_sub_u32 s97, s97, 1
    s_cbranch_scc1 L_dead
    s_cmp_ge_u32 s40, s53
    s_cbranch_scc1 L_ok35
    s_sleep 1
    s_branch L_sp34
L_ok35:
    ds_read_b128 v[56:59], v140 offset:32768
    ds_read_b128 v[60:63], v141 offset:32768
    ds_read_b128 v[64:67], v142 offset:32768
    ds_read_b128 v[68:71], v143 offset:32768
    buffer_load_dwordx4 v[150:153], v146, s[60:63], s51 offen offset:0 sc1
    buffer_load_dwordx4 v[154:157], v146, s[60:63], s51 offen offset:1024 sc1
    s_cmp_lg_u32 s39, 3
    s_cbranch_scc1 L_q1
    buffer_load_dwordx4 v[158:161], v146, s[60:63], s50 offen offset:0 sc1
    buffer_load_dwordx4 v[162:165], v146, s[60:63], s50 offen offset:1024 sc1
L_q1:
    s_add_u32 s53, s53, 7
    s_waitcnt lgkmcnt(0)
    v_mov_b32 v3, s53
    ds_write_b32 v2, v3
    s_add_u32 s53, s3, 49
    s_cmp_ge_u32 s40, s53
    s_cbranch_scc1 L_ok37
L_sp36:
    ds_read_b32 v3, v1 offset:0
    s_waitcnt lgkmcnt(0)
    v_readfirstlane_b32 s40, v3
    s_sub_u32 s97, s97, 1
    s_cbranch_scc1 L_dead
    s_cmp_ge_u32 s40, s53
    s_cbranch_scc1 L_ok37
    s_sleep 1
    s_branch L_sp36
L_ok37:
    v_xor_b32 v140, 0x10000, v140
    v_xor_b32 v141, 0x10000, v141
    v_xor_b32 v142, 0x10000, v142
    v_xor_b32 v143, 0x10000, v143
    ds_read_b128 v[72:75], v140 offset:0
    ds_read_b128 v[76:79], v141 offset:0
    ds_read_b128 v[80:83], v142 offset:0
    ds_read_b128 v[84:87], v143 offset:0
    s_mov_b32 s53, 56
    s_waitcnt lgkmcnt(0)
    v_mov_b32 v3, s53
    ds_write_b32 v2, v3
    s_mov_b32 s64, 0
    s_branch L_ck39
L_ag38:
L_pk40:
    s_wqm_b64 exec, s[42:43]
    s_cbranch_execz L_sk41
    buffer_load_dwordx4 v[150:153], v146, s[60:63], s51 offen offset:0 sc1
L_sk41:
    s_wqm_b64 exec, s[44:45]
    s_cbranch_execz L_sk42
    buffer_load_dwordx4 v[154:157], v146, s[60:63], s51 offen offset:1024 sc1
L_sk42:
    s_wqm_b64 exec, s[46:47]
    s_cbranch_execz L_sk43
    buffer_load_dwordx4 v[158:161], v146, s[60:63], s50 offen offset:0 sc1
L_sk43:
    s_wqm_b64 exec, s[48:49]
    s_cbranch_execz L_sk44
    buffer_load_dwordx4 v[162:165], v146, s[60:63], s50 offen offset:1024 sc1
L_sk44:
    s_mov_b64 exec, -1
L_ck39:
    s_waitcnt vmcnt(0)
    v_perm_b32 v4, v150, v151, s36
    v_perm_b32 v5, v152, v153, s36
    v_lshl_or_b32 v4, v5, 16, v4
    v_cmp_ne_u32 s[42:43], s38, v4
    v_perm_b32 v4, v154, v155, s36
    v_perm_b32 v5, v156, v157, s36
    v_lshl_or_b32 v4, v5, 16, v4
    v_cmp_ne_u32 s[44:45], s38, v4
    v_perm_b32 v4, v158, v159, s36
    v_perm_b32 v5, v160, v161, s36
    v_lshl_or_b32 v4, v5, 16, v4
    v_cmp_ne_u32 s[46:47], s38, v4
    v_perm_b32 v4, v162, v163, s36
    v_perm_b32 v5, v164, v165, s36
    v_lshl_or_b32 v4, v5, 16, v4
    v_cmp_ne_u32 s[48:49], s38, v4
    s_add_u32 s64, s64, 1
    s_sub_u32 s97, s97, 64
    s_cbranch_scc1 L_dead
    s_or_b64 vcc, s[42:43], s[44:45]
    s_or_b64 vcc, vcc, s[46:47]
    s_or_b64 vcc, vcc, s[48:49]
    s_cbranch_scc1 L_ag38
    s_cmp_eq_u32 s39, 3
    s_cselect_b64 s[66:67], -1, 0
    v_add_f32 v154, v150, v154
    v_add_f32 v150, v158, v162
    v_add_f32 v155, v151, v155
    v_add_f32 v151, v159, v163
    v_add_f32 v156, v152, v156
    v_add_f32 v152, v160, v164
    v_add_f32 v157, v153, v157
    v_add_f32 v153, v161, v165
    v_cndmask_b32 v150, v154, v150, s[66:67]
    v_cndmask_b32 v151, v155, v151, s[66:67]
    v_cndmask_b32 v152, v156, v152, s[66:67]
    v_cndmask_b32 v153, v157, v153, s[66:67]
    s_nop 0
    v_permlane32_swap_b32 v150, v154
    v_permlane32_swap_b32 v151, v155
    v_permlane32_swap_b32 v152, v156
    v_permlane32_swap_b32 v153, v157
    v_add_f32 v150, v150, v154
    v_add_f32 v151, v151, v155
    v_add_f32 v152, v152, v156
    v_add_f32 v153, v153, v157
    v_cvt_pk_bf16_f32 v154, v150, v151
    v_cvt_pk_bf16_f32 v155, v152, v153
    ds_write_b16 v147, v154
    ds_write_b16_d16_hi v147, v154 offset:16
    ds_write_b16 v147, v155 offset:32
    ds_write_b16_d16_hi v147, v155 offset:48
    v_and_b32 v5, 7, v0
    v_lshrrev_b32 v6, 4, v0
    v_mul_u32_u24 v4, 272, v5
    v_lshl_add_u32 v4, v6, 4, v4
    v_add_u32 v4, 135424, v4
    v_lshlrev_b32 v146, 7, v6
    v_lshl_add_u32 v146, v5, 4, v146
    v_lshlrev_b32 v147, 5, v5
    v_add_u32 v147, 150016, v147
    s_mov_b32 s56, 0x3e0293ee
    s_mov_b32 s66, 0xff00ff00
    s_mov_b32 s67, 0xff00ff00
    s_waitcnt lgkmcnt(0)
    s_mov_b64 exec, 1
    v_mov_b32 v3, 1
    ds_add_u32 v1, v3 offset:4
    s_mov_b64 exec, -1
L_sp45:
    ds_read_b32 v3, v1 offset:4
    s_waitcnt lgkmcnt(0)
    v_readfirstlane_b32 s41, v3
    s_sub_u32 s97, s97, 1
    s_cbranch_scc1 L_dead
    s_cmp_ge_u32 s41, 8
    s_cbranch_scc1 L_ok46
    s_sleep 1
    s_branch L_sp45
L_ok46:
    ds_read_b128 v[88:91], v4 offset:0
    ds_read_b128 v[92:95], v4 offset:64
    ds_read_b128 v[96:99], v4 offset:128
    ds_read_b128 v[100:103], v4 offset:192
    ds_read_b128 v[104:107], v4 offset:2176
    ds_read_b128 v[108:111], v4 offset:2240
    ds_read_b128 v[112:115], v4 offset:2304
    ds_read_b128 v[116:119], v4 offset:2368
    v_and_b32 v7, 15, v0
    v_lshlrev_b32 v7, 5, v7
    s_lshl_b32 s54, s3, 2
    s_add_u32 s54, s54, 150016
    v_add_u32 v7, s54, v7
    s_lshr_b32 s54, s3, 1
    s_lshl_b32 s54, s54, 9
    s_and_b32 s55, s3, 1
    s_lshl_b32 s55, s55, 3
    s_add_u32 s54, s54, s55
    s_add_u32 s54, s54, 139776
    v_add_u32 v6, s54, v146
    v_add_u32 v148, 139776, v146
    s_waitcnt lgkmcnt(0)
    v_mfma_f32_16x16x32_bf16 v[120:123], v[8:11], v[88:91], 0
    v_mfma_f32_16x16x32_bf16 v[124:127], v[24:27], v[104:107], 0
    v_mfma_f32_16x16x32_bf16 v[128:131], v[40:43], v[104:107], 0
    v_mfma_f32_16x16x32_bf16 v[132:135], v[56:59], v[104:107], 0
    v_mfma_f32_16x16x32_bf16 v[136:139], v[72:75], v[104:107], 0
    v_mfma_f32_16x16x32_bf16 v[120:123], v[12:15], v[92:95], v[120:123]
    v_mfma_f32_16x16x32_bf16 v[124:127], v[28:31], v[108:111], v[124:127]
    v_mfma_f32_16x16x32_bf16 v[128:131], v[44:47], v[108:111], v[128:131]
    v_mfma_f32_16x16x32_bf16 v[132:135], v[60:63], v[108:111], v[132:135]
    v_mfma_f32_16x16x32_bf16 v[136:139], v[76:79], v[108:111], v[136:139]
    v_mfma_f32_16x16x32_bf16 v[120:123], v[16:19], v[96:99], v[120:123]
    v_mfma_f32_16x16x32_bf16 v[124:127], v[32:35], v[112:115], v[124:127]
    v_mfma_f32_16x16x32_bf16 v[128:131], v[48:51], v[112:115], v[128:131]
    v_mfma_f32_16x16x32_bf16 v[132:135], v[64:67], v[112:115], v[132:135]
    v_mfma_f32_16x16x32_bf16 v[136:139], v[80:83], v[112:115], v[136:139]
    v_mfma_f32_16x16x32_bf16 v[120:123], v[20:23], v[100:103], v[120:123]
    v_mfma_f32_16x16x32_bf16 v[124:127], v[36:39], v[116:119], v[124:127]
    v_mfma_f32_16x16x32_bf16 v[128:131], v[52:55], v[116:119], v[128:131]
    v_mfma_f32_16x16x32_bf16 v[132:135], v[68:71], v[116:119], v[132:135]
    v_mfma_f32_16x16x32_bf16 v[136:139], v[84:87], v[116:119], v[136:139]
    s_nop 7
    v_max3_f32 v150, v120, v121, v122
    v_max3_f32 v151, v124, v125, v126
    v_max_f32 v150, v150, v123
    v_max3_f32 v151, v151, v127, v128
    v_max3_f32 v151, v151, v129, v130
    v_max3_f32 v151, v151, v131, v132
    v_max3_f32 v151, v151, v133, v134
    v_max3_f32 v151, v151, v135, v136
    v_max3_f32 v151, v151, v137, v138
    v_max_f32 v151, v151, v139
    v_cndmask_b32 v150, v150, v151, s[66:67]
    v_mov_b32 v152, v150
    s_nop 1
    v_permlane16_swap_b32 v150, v152
    s_nop 0
    v_max_f32 v150, v150, v152
    v_mov_b32 v152, v150
    s_nop 1
    v_permlane32_swap_b32 v150, v152
    s_nop 0
    v_max_f32 v150, v150, v152
    ds_write_b32 v7, v150
    s_waitcnt lgkmcnt(0)
    s_mov_b64 exec, 1
    v_mov_b32 v3, 1
    ds_add_u32 v1, v3 offset:4
    s_mov_b64 exec, -1
L_sp47:
    ds_read_b32 v3, v1 offset:4
    s_waitcnt lgkmcnt(0)
    v_readfirstlane_b32 s41, v3
    s_sub_u32 s97, s97, 1
    s_cbranch_scc1 L_dead
    s_cmp_ge_u32 s41, 16
    s_cbranch_scc1 L_ok48
    s_sleep 1
    s_branch L_sp47
L_ok48:
    ds_read_b128 v[88:91], v147 offset:0
    ds_read_b128 v[92:95], v147 offset:16
    ds_read_b128 v[96:99], v147 offset:256
    ds_read_b128 v[100:103], v147 offset:272
    s_waitcnt lgkmcnt(2)
    v_max3_f32 v160, v88, v89, v90
    v_max3_f32 v160, v160, v91, v92
    v_max3_f32 v160, v160, v93, v94
    v_max_f32 v160, v160, v95
    s_waitcnt lgkmcnt(0)
    v_max3_f32 v164, v96, v97, v98
    v_max3_f32 v164, v164, v99, v100
    v_max3_f32 v164, v164, v101, v102
    v_max_f32 v164, v164, v103
    s_cmp_eq_u32 s39, 3
    s_cbranch_scc1 L_nm1
    v_max_f32 v160, v160, v164
    v_mov_b32 v164, v160
L_nm1:
    v_mul_f32 v160, s56, v160
    v_bfi_b32 v160, v166, s4, v160
    v_mul_f32 v164, s56, v164
    v_bfi_b32 v164, v166, s4, v164
    v_fma_f32 v120, v120, s56, -v160
    v_fma_f32 v121, v121, s56, -v160
    v_fma_f32 v122, v122, s56, -v160
    v_fma_f32 v123, v123, s56, -v160
    v_fma_f32 v124, v124, s56, -v164
    v_fma_f32 v125, v125, s56, -v164
    v_fma_f32 v126, v126, s56, -v164
    v_fma_f32 v127, v127, s56, -v164
    v_fma_f32 v128, v128, s56, -v164
    v_fma_f32 v129, v129, s56, -v164
    v_fma_f32 v130, v130, s56, -v164
    v_fma_f32 v131, v131, s56, -v164
    v_fma_f32 v132, v132, s56, -v164
    v_fma_f32 v133, v133, s56, -v164
    v_fma_f32 v134, v134, s56, -v164
    v_fma_f32 v135, v135, s56, -v164
    v_fma_f32 v136, v136, s56, -v164
    v_fma_f32 v137, v137, s56, -v164
    v_fma_f32 v138, v138, s56, -v164
    v_fma_f32 v139, v139, s56, -v164
    v_exp_f32 v120, v120
    v_exp_f32 v121, v121
    v_exp_f32 v122, v122
    v_exp_f32 v123, v123
    v_exp_f32 v124, v124
    v_exp_f32 v125, v125
    v_exp_f32 v126, v126
    v_exp_f32 v127, v127
    v_exp_f32 v128, v128
    v_exp_f32 v129, v129
    v_exp_f32 v130, v130
    v_exp_f32 v131, v131
    v_exp_f32 v132, v132
    v_exp_f32 v133, v133
    v_exp_f32 v134, v134
    v_exp_f32 v135, v135
    v_exp_f32 v136, v136
    v_exp_f32 v137, v137
    v_exp_f32 v138, v138
    v_exp_f32 v139, v139
    s_mov_b32 exec_lo, 0x00ff00ff
    s_mov_b32 exec_hi, 0x00ff00ff
    v_cvt_pk_bf16_f32 v88, v120, v121
    v_cvt_pk_bf16_f32 v89, v122, v123
    ds_write_b64 v6, v[88:89] offset:0
    v_cvt_pk_bf16_f32 v90, v124, v125
    v_cvt_pk_bf16_f32 v91, v126, v127
    ds_write_b64 v6, v[90:91] offset:2048
    v_cvt_pk_bf16_f32 v92, v128, v129
    v_cvt_pk_bf16_f32 v93, v130, v131
    ds_write_b64 v6, v[92:93] offset:4096
    v_cvt_pk_bf16_f32 v94, v132, v133
    v_cvt_pk_bf16_f32 v95, v134, v135
    ds_write_b64 v6, v[94:95] offset:6144
    v_cvt_pk_bf16_f32 v96, v136, v137
    v_cvt_pk_bf16_f32 v97, v138, v139
    ds_write_b64 v6, v[96:97] offset:8192
    s_mov_b64 exec, -1
    v_add_f32 v150, v120, v121
    v_add_f32 v151, v124, v125
    v_add_f32 v150, v150, v122
    v_add_f32 v150, v150, v123
    v_add_f32 v151, v151, v126
    v_add_f32 v151, v151, v127
    v_add_f32 v151, v151, v128
    v_add_f32 v151, v151, v129
    v_add_f32 v151, v151, v130
    v_add_f32 v151, v151, v131
    v_add_f32 v151, v151, v132
    v_add_f32 v151, v151, v133
    v_add_f32 v151, v151, v134
    v_add_f32 v151, v151, v135
    v_add_f32 v151, v151, v136
    v_add_f32 v151, v151, v137
    v_add_f32 v151, v151, v138
    v_add_f32 v151, v151, v139
    v_cndmask_b32 v150, v150, v151, s[66:67]
    v_mov_b32 v152, v150
    s_nop 1
    v_permlane16_swap_b32 v150, v152
    s_nop 0
    v_add_f32 v150, v150, v152
    v_mov_b32 v152, v150
    s_nop 1
    v_permlane32_swap_b32 v150, v152
    s_nop 0
    v_add_f32 v150, v150, v152
    ds_write_b32 v7, v150 offset:512
    s_waitcnt lgkmcnt(0)
    s_mov_b64 exec, 1
    v_mov_b32 v3, 1
    ds_add_u32 v1, v3 offset:4
    s_mov_b64 exec, -1
L_sp49:
    ds_read_b32 v3, v1 offset:4
    s_waitcnt lgkmcnt(0)
    v_readfirstlane_b32 s41, v3
    s_sub_u32 s97, s97, 1
    s_cbranch_scc1 L_dead
    s_cmp_ge_u32 s41, 24
    s_cbranch_scc1 L_ok50
    s_sleep 1
    s_branch L_sp49
L_ok50:
    ds_read_b128 v[88:91], v147 offset:512
    ds_read_b128 v[92:95], v147 offset:528
    ds_read_b128 v[96:99], v147 offset:768
    ds_read_b128 v[100:103], v147 offset:784
    ds_read_b128 v[8:11], v148 offset:0
    ds_read_b128 v[12:15], v148 offset:512
    ds_read_b128 v[16:19], v148 offset:1024
    ds_read_b128 v[20:23], v148 offset:1536
    ds_read_b128 v[24:27], v148 offset:2048
    ds_read_b128 v[28:31], v148 offset:2560
    ds_read_b128 v[32:35], v148 offset:3072
    ds_read_b128 v[36:39], v148 offset:3584
    ds_read_b128 v[40:43], v148 offset:4096
    ds_read_b128 v[44:47], v148 offset:4608
    s_waitcnt lgkmcnt(10)
    v_add_f32 v161, v88, v89
    v_add_f32 v161, v161, v90
    v_add_f32 v161, v161, v91
    v_add_f32 v161, v161, v92
    v_add_f32 v161, v161, v93
    v_add_f32 v161, v161, v94
    v_add_f32 v161, v161, v95
    v_add_f32 v165, v96, v97
    v_add_f32 v165, v165, v98
    v_add_f32 v165, v165, v99
    v_add_f32 v165, v165, v100
    v_add_f32 v165, v165, v101
    v_add_f32 v165, v165, v102
    v_add_f32 v165, v165, v103
    s_cmp_eq_u32 s39, 3
    s_cbranch_scc1 L_nm2
    v_add_f32 v165, v165, v161
L_nm2:
    v_bfi_b32 v161, v166, s35, v161
    v_bfi_b32 v165, v166, s35, v165
    s_waitcnt lgkmcnt(0)
    ds_read_b128 v[48:51], v148 offset:5120
    ds_read_b128 v[52:55], v148 offset:5632
    ds_read_b128 v[56:59], v148 offset:6144
    ds_read_b128 v[60:63], v148 offset:6656
    ds_read_b128 v[64:67], v148 offset:7168
    ds_read_b128 v[68:71], v148 offset:7680
    ds_read_b128 v[72:75], v148 offset:8192
    ds_read_b128 v[76:79], v148 offset:8704
    ds_read_b128 v[80:83], v148 offset:9216
    ds_read_b128 v[84:87], v148 offset:9728
L_dry:
    s_lshl_b32 s54, s30, 3
    s_add_u32 s52, s54, s3
    s_mul_i32 s52, s52, 34816
    s_lshl_b32 s55, s31, 9
    s_add_u32 s52, s52, s55
    s_add_u32 s52, s52, 1048576
    s_cmp_le_u32 s39, 2
    s_cselect_b32 s59, 0, 1112576
    s_add_u32 s59, s59, s52
    s_bfe_u32 s55, s31, 0x30002
    s_add_u32 s58, s54, s55
    s_mul_i32 s50, s58, 34816
    s_lshr_b32 s55, s31, 5
    s_mul_i32 s55, s55, 1114112
    s_add_u32 s50, s50, s55
    s_lshr_b32 s55, s3, 1
    s_lshl_b32 s54, s55, 13
    s_add_u32 s50, s50, s54
    s_and_b32 s54, s3, 1
    s_lshl_b32 s57, s54, 8
    s_add_u32 s50, s50, s57
    s_add_u32 s50, s50, 1048576
    s_add_u32 s51, s50, 4096
    s_mul_i32 s55, s55, 320
    s_lshl_b32 s54, s54, 1
    s_sub_u32 s54, s54, s32
    s_add_u32 s55, s55, 151040
    v_lshrrev_b32 v4, 4, v0
    v_and_b32 v5, 15, v0
    v_lshlrev_b32 v140, 9, v4
    v_lshl_add_u32 v140, v5, 4, v140
    v_lshrrev_b32 v6, 3, v5
    v_add_u32 v6, s54, v6
    v_and_b32 v6, 3, v6
    v_and_b32 v141, 7, v0
    v_lshlrev_b32 v141, 3, v141
    v_lshl_add_u32 v141, v6, 6, v141
    v_lshl_add_u32 v141, v4, 1, v141
    v_add_u32 v141, s55, v141
    v_bfe_u32 v5, v0, 2, 2
    v_lshlrev_b32 v142, 12, v4
    v_lshl_add_u32 v142, v5, 9, v142
    v_and_b32 v6, 1, v4
    v_lshl_add_u32 v6, v6, 2, v5
    s_lshl_b32 s54, s3, 1
    v_xor_b32 v6, s54, v6
    v_lshl_add_u32 v142, v6, 5, v142
    v_and_b32 v5, 3, v0
    v_lshl_add_u32 v142, v5, 3, v142
    v_xor_b32 v143, 32, v142
    v_bfe_u32 v6, v0, 2, 1
    v_and_b32 v5, 1, v0
    v_lshl_add_u32 v5, v6, 1, v5
    v_mul_u32_u24 v147, 320, v5
    v_lshl_add_u32 v147, v4, 4, v147
    v_add_u32 v147, 151040, v147
    v_bfe_u32 v5, v0, 3, 2
    v_and_b32 v6, 7, v0
    v_lshlrev_b32 v149, 15, v5
    v_lshl_add_u32 v149, v6, 4, v149
    v_lshlrev_b32 v5, 3, v5
    s_xor_b32 s54, s58, s3
    v_xor_b32 v5, s54, v5
    v_lshl_add_u32 v149, v5, 7, v149
    s_lshr_b32 s54, s31, 5
    s_lshl_b32 s54, s54, 2
    s_and_b32 s55, s31, 3
    s_add_u32 s54, s54, s55
    s_lshl_b32 s54, s54, 5
    s_add_u32 s54, s54, s3
    s_lshl_b32 s54, s54, 12
    s_add_u32 s55, s54, 4194304
    s_cmp_ge_u32 s40, 60
    s_cbranch_scc1 L_ok52
L_sp51:
    ds_read_b32 v3, v1 offset:0
    s_waitcnt lgkmcnt(0)
    v_readfirstlane_b32 s40, v3
    s_sub_u32 s97, s97, 1
    s_cbranch_scc1 L_dead
    s_cmp_ge_u32 s40, 60
    s_cbranch_scc1 L_ok52
    s_sleep 1
    s_branch L_sp51
L_ok52:
    ds_read_b64_tr_b16 v[88:89], v145 offset:32768
    ds_read_b64_tr_b16 v[90:91], v145 offset:36864
    ds_read_b64_tr_b16 v[92:93], v145 offset:40960
    ds_read_b64_tr_b16 v[94:95], v145 offset:45056
    s_waitcnt lgkmcnt(2)
    v_mfma_f32_16x16x32_bf16 v[150:153], v[88:91], v[8:11], 0
    s_waitcnt lgkmcnt(0)
    v_mfma_f32_16x16x32_bf16 v[150:153], v[92:95], v[12:15], v[150:153]
    v_mov_b32 v3, 60
    ds_write_b32 v2, v3
    s_cmp_ge_u32 s40, 64
    s_cbranch_scc1 L_ok54
L_sp53:
    ds_read_b32 v3, v1 offset:0
    s_waitcnt lgkmcnt(0)
    v_readfirstlane_b32 s40, v3
    s_sub_u32 s97, s97, 1
    s_cbranch_scc1 L_dead
    s_cmp_ge_u32 s40, 64
    s_cbranch_scc1 L_ok54
    s_sleep 1
    s_branch L_sp53
L_ok54:
    ds_read_b64_tr_b16 v[88:89], v145 offset:49152
    ds_read_b64_tr_b16 v[90:91], v145 offset:53248
    ds_read_b64_tr_b16 v[92:93], v145 offset:57344
    ds_read_b64_tr_b16 v[94:95], v145 offset:61440
    s_waitcnt lgkmcnt(2)
    v_mfma_f32_16x16x32_bf16 v[150:153], v[88:91], v[16:19], v[150:153]
    s_waitcnt lgkmcnt(0)
    v_mfma_f32_16x16x32_bf16 v[150:153], v[92:95], v[20:23], v[150:153]
    v_mov_b32 v3, 64
    ds_write_b32 v2, v3
    s_cmp_lg_u32 s39, 3
    s_cbranch_scc1 L_np158
    s_nop 7
    v_cvt_pk_bf16_f32 v158, v150, v151
    v_cvt_pk_bf16_f32 v159, v152, v153
    s_mov_b32 exec_lo, 0x00ff00ff
    s_mov_b32 exec_hi, 0x00ff00ff
    buffer_store_dwordx4 v[158:161], v146, s[60:63], s52 offen sc1
    s_mov_b64 exec, -1
    v_mov_b32 v150, 0
    v_mov_b32 v151, 0
    v_mov_b32 v152, 0
    v_mov_b32 v153, 0
L_np158:
    s_cmp_ge_u32 s40, 68
    s_cbranch_scc1 L_ok56
L_sp55:
    ds_read_b32 v3, v1 offset:0
    s_waitcnt lgkmcnt(0)
    v_readfirstlane_b32 s40, v3
    s_sub_u32 s97, s97, 1
    s_cbranch_scc1 L_dead
    s_cmp_ge_u32 s40, 68
    s_cbranch_scc1 L_ok56
    s_sleep 1
    s_branch L_sp55
L_ok56:
    ds_read_b64_tr_b16 v[88:89], v144 offset:0
    ds_read_b64_tr_b16 v[90:91], v144 offset:4096
    ds_read_b64_tr_b16 v[92:93], v144 offset:8192
    ds_read_b64_tr_b16 v[94:95], v144 offset:12288
    s_waitcnt lgkmcnt(2)
    v_mfma_f32_16x16x32_bf16 v[150:153], v[88:91], v[24:27], v[150:153]
    s_waitcnt lgkmcnt(0)
    v_mfma_f32_16x16x32_bf16 v[150:153], v[92:95], v[28:31], v[150:153]
    v_mov_b32 v3, 68
    ds_write_b32 v2, v3
    s_cmp_ge_u32 s40, 72
    s_cbranch_scc1 L_ok58
L_sp57:
    ds_read_b32 v3, v1 offset:0
    s_waitcnt lgkmcnt(0)
    v_readfirstlane_b32 s40, v3
    s_sub_u32 s97, s97, 1
    s_cbranch_scc1 L_dead
    s_cmp_ge_u32 s40, 72
    s_cbranch_scc1 L_ok58
    s_sleep 1
    s_branch L_sp57
L_ok58:
    ds_read_b64_tr_b16 v[88:89], v144 offset:16384
    ds_read_b64_tr_b16 v[90:91], v144 offset:20480
    ds_read_b64_tr_b16 v[92:93], v144 offset:24576
    ds_read_b64_tr_b16 v[94:95], v144 offset:28672
    s_waitcnt lgkmcnt(2)
    v_mfma_f32_16x16x32_bf16 v[150:153], v[88:91], v[32:35], v[150:153]
    s_waitcnt lgkmcnt(0)
    v_mfma_f32_16x16x32_bf16 v[150:153], v[92:95], v[36:39], v[150:153]
    v_mov_b32 v3, 72
    ds_write_b32 v2, v3
    s_cmp_ge_u32 s40, 76
    s_cbranch_scc1 L_ok60
L_sp59:
    ds_read_b32 v3, v1 offset:0
    s_waitcnt lgkmcnt(0)
    v_readfirstlane_b32 s40, v3
    s_sub_u32 s97, s97, 1
    s_cbranch_scc1 L_dead
    s_cmp_ge_u32 s40, 76
    s_cbranch_scc1 L_ok60
    s_sleep 1
    s_branch L_sp59
L_ok60:
    ds_read_b64_tr_b16 v[88:89], v144 offset:32768
    ds_read_b64_tr_b16 v[90:91], v144 offset:36864
    ds_read_b64_tr_b16 v[92:93], v144 offset:40960
    ds_read_b64_tr_b16 v[94:95], v144 offset:45056
    s_waitcnt lgkmcnt(2)
    v_mfma_f32_16x16x32_bf16 v[150:153], v[88:91], v[40:43], v[150:153]
    s_waitcnt lgkmcnt(0)
    v_mfma_f32_16x16x32_bf16 v[150:153], v[92:95], v[44:47], v[150:153]
    v_mov_b32 v3, 76
    ds_write_b32 v2, v3
    s_cmp_ge_u32 s40, 80
    s_cbranch_scc1 L_ok62
L_sp61:
    ds_read_b32 v3, v1 offset:0
    s_waitcnt lgkmcnt(0)
    v_readfirstlane_b32 s40, v3
    s_sub_u32 s97, s97, 1
    s_cbranch_scc1 L_dead
    s_cmp_ge_u32 s40, 80
    s_cbranch_scc1 L_ok62
    s_sleep 1
    s_branch L_sp61
L_ok62:
    ds_read_b64_tr_b16 v[88:89], v144 offset:49152
    ds_read_b64_tr_b16 v[90:91], v144 offset:53248
    ds_read_b64_tr_b16 v[92:93], v144 offset:57344
    ds_read_b64_tr_b16 v[94:95], v144 offset:61440
    s_waitcnt lgkmcnt(2)
    v_mfma_f32_16x16x32_bf16 v[150:153], v[88:91], v[48:51], v[150:153]
    s_waitcnt lgkmcnt(0)
    v_mfma_f32_16x16x32_bf16 v[150:153], v[92:95], v[52:55], v[150:153]
    v_mov_b32 v3, 80
    ds_write_b32 v2, v3
    s_cmp_ge_u32 s40, 84
    s_cbranch_scc1 L_ok64
L_sp63:
    ds_read_b32 v3, v1 offset:0
    s_waitcnt lgkmcnt(0)
    v_readfirstlane_b32 s40, v3
    s_sub_u32 s97, s97, 1
    s_cbranch_scc1 L_dead
    s_cmp_ge_u32 s40, 84
    s_cbranch_scc1 L_ok64
    s_sleep 1
    s_branch L_sp63
L_ok64:
    ds_read_b64_tr_b16 v[88:89], v145 offset:0
    ds_read_b64_tr_b16 v[90:91], v145 offset:4096
    ds_read_b64_tr_b16 v[92:93], v145 offset:8192
    ds_read_b64_tr_b16 v[94:95], v145 offset:12288
    s_waitcnt lgkmcnt(2)
    v_mfma_f32_16x16x32_bf16 v[150:153], v[88:91], v[56:59], v[150:153]
    s_waitcnt lgkmcnt(0)
    v_mfma_f32_16x16x32_bf16 v[150:153], v[92:95], v[60:63], v[150:153]
    s_cmp_ge_u32 s40, 88
    s_cbranch_scc1 L_ok66
L_sp65:
    ds_read_b32 v3, v1 offset:0
    s_waitcnt lgkmcnt(0)
    v_readfirstlane_b32 s40, v3
    s_sub_u32 s97, s97, 1
    s_cbranch_scc1 L_dead
    s_cmp_ge_u32 s40, 88
    s_cbranch_scc1 L_ok66
    s_sleep 1
    s_branch L_sp65
L_ok66:
    ds_read_b64_tr_b16 v[88:89], v145 offset:16384
    ds_read_b64_tr_b16 v[90:91], v145 offset:20480
    ds_read_b64_tr_b16 v[92:93], v145 offset:24576
    ds_read_b64_tr_b16 v[94:95], v145 offset:28672
    s_waitcnt lgkmcnt(2)
    v_mfma_f32_16x16x32_bf16 v[150:153], v[88:91], v[64:67], v[150:153]
    s_waitcnt lgkmcnt(0)
    v_mfma_f32_16x16x32_bf16 v[150:153], v[92:95], v[68:71], v[150:153]
    v_mov_b32 v4, 0xf149f2ca
    s_mov_b64 s[42:43], -1
    s_cmp_ge_u32 s31, 32
    s_cselect_b64 s[44:45], -1, 0
    s_cselect_b64 s[46:47], -1, 0
    s_cselect_b32 s48, 0xffff, 0
    s_mov_b32 s49, 0
    v_mov_b32 v12, 0
    v_mov_b32 v13, 0
    v_bfi_b32 v14, v166, s4, v4
    v_mov_b32 v15, s35
    v_mov_b32 v16, 0
    v_mov_b32 v17, 0
    v_bfi_b32 v18, v166, s4, v4
    v_mov_b32 v19, s35
    v_mov_b32 v20, 0
    v_mov_b32 v21, 0
    v_bfi_b32 v22, v166, s4, v4
    v_mov_b32 v23, s35
    s_cmp_ge_u32 s40, 92
    s_cbranch_scc1 L_ok68
L_sp67:
    ds_read_b32 v3, v1 offset:0
    s_waitcnt lgkmcnt(0)
    v_readfirstlane_b32 s40, v3
    s_sub_u32 s97, s97, 1
    s_cbranch_scc1 L_dead
    s_cmp_ge_u32 s40, 92
    s_cbranch_scc1 L_ok68
    s_sleep 1
    s_branch L_sp67
L_ok68:
    ds_read_b64_tr_b16 v[88:89], v145 offset:32768
    ds_read_b64_tr_b16 v[90:91], v145 offset:36864
    ds_read_b64_tr_b16 v[92:93], v145 offset:40960
    ds_read_b64_tr_b16 v[94:95], v145 offset:45056
    s_waitcnt lgkmcnt(2)
    v_mfma_f32_16x16x32_bf16 v[150:153], v[88:91], v[72:75], v[150:153]
    s_waitcnt lgkmcnt(0)
    v_mfma_f32_16x16x32_bf16 v[150:153], v[92:95], v[76:79], v[150:153]
    s_cmp_ge_u32 s40, 94
    s_cbranch_scc1 L_ok70
L_sp69:
    ds_read_b32 v3, v1 offset:0
    s_waitcnt lgkmcnt(0)
    v_readfirstlane_b32 s40, v3
    s_sub_u32 s97, s97, 1
    s_cbranch_scc1 L_dead
    s_cmp_ge_u32 s40, 94
    s_cbranch_scc1 L_ok70
    s_sleep 1
    s_branch L_sp69
L_ok70:
    ds_read_b64_tr_b16 v[88:89], v145 offset:49152
    ds_read_b64_tr_b16 v[90:91], v145 offset:53248
    s_waitcnt lgkmcnt(0)
    v_mfma_f32_16x16x32_bf16 v[150:153], v[88:91], v[80:83], v[150:153]
    s_cmp_ge_u32 s40, 96
    s_cbranch_scc1 L_ok72
L_sp71:
    ds_read_b32 v3, v1 offset:0
    s_waitcnt lgkmcnt(0)
    v_readfirstlane_b32 s40, v3
    s_sub_u32 s97, s97, 1
    s_cbranch_scc1 L_dead
    s_cmp_ge_u32 s40, 96
    s_cbranch_scc1 L_ok72
    s_branch L_sp71
L_ok72:
    ds_read_b64_tr_b16 v[88:89], v145 offset:57344
    ds_read_b64_tr_b16 v[90:91], v145 offset:61440
    s_waitcnt lgkmcnt(0)
    v_mfma_f32_16x16x32_bf16 v[150:153], v[88:91], v[84:87], v[150:153]
    s_nop 7
    v_cvt_pk_bf16_f32 v162, v150, v151
    v_cvt_pk_bf16_f32 v163, v152, v153
    s_mov_b32 exec_lo, 0x00ff00ff
    s_mov_b32 exec_hi, 0x00ff00ff
    buffer_store_dwordx4 v[162:165], v146, s[60:63], s59 offen sc1
    s_mov_b64 exec, -1
    s_cmp_ge_u32 s40, 103
    s_cbranch_scc1 L_ok74
L_sp73:
    ds_read_b32 v3, v1 offset:0
    s_waitcnt lgkmcnt(0)
    v_readfirstlane_b32 s40, v3
    s_sub_u32 s97, s97, 1
    s_cbranch_scc1 L_dead
    s_cmp_ge_u32 s40, 103
    s_cbranch_scc1 L_ok74
    s_sleep 1
    s_branch L_sp73
L_ok74:
    s_mov_b64 exec, s[42:43]
    s_cbranch_execz L_sk75
    buffer_load_dwordx4 v[8:11], v140, s[60:63], s50 offen offset:0 sc1
L_sk75:
    s_mov_b64 exec, s[44:45]
    s_cbranch_execz L_sk76
    buffer_load_dwordx4 v[12:15], v140, s[60:63], s50 offen offset:2048 sc1
L_sk76:
    s_mov_b64 exec, s[46:47]
    s_cbranch_execz L_sk77
    buffer_load_dwordx4 v[16:19], v140, s[60:63], s51 offen offset:0 sc1
L_sk77:
    s_mov_b64 exec, s[48:49]
    s_cbranch_execz L_sk78
    buffer_load_dwordx4 v[20:23], v140, s[60:63], s51 offen offset:2048 sc1
L_sk78:
    s_mov_b64 exec, -1
    s_cmp_ge_u32 s40, 104
    s_cbranch_scc1 L_ok80
L_sp79:
    ds_read_b32 v3, v1 offset:0
    s_waitcnt lgkmcnt(0)
    v_readfirstlane_b32 s40, v3
    s_sub_u32 s97, s97, 1
    s_cbranch_scc1 L_dead
    s_cmp_ge_u32 s40, 104
    s_cbranch_scc1 L_ok80
    s_sleep 1
    s_branch L_sp79
L_ok80:
    ds_read_b64_tr_b16 v[96:97], v142 offset:0
    ds_read_b64_tr_b16 v[98:99], v142 offset:2048
    ds_read_b64_tr_b16 v[100:101], v143 offset:0
    ds_read_b64_tr_b16 v[102:103], v143 offset:2048
    ds_read_b64_tr_b16 v[104:105], v142 offset:16384
    ds_read_b64_tr_b16 v[106:107], v142 offset:18432
    ds_read_b64_tr_b16 v[108:109], v143 offset:16384
    ds_read_b64_tr_b16 v[110:111], v143 offset:18432
    s_mov_b32 s64, 0
    s_branch L_ck82
L_ag81:
    s_cmp_ge_u32 s40, 107
    s_cbranch_scc1 L_ok85
L_sp84:
    ds_read_b32 v3, v1 offset:0
    s_waitcnt lgkmcnt(0)
    v_readfirstlane_b32 s40, v3
    s_sub_u32 s97, s97, 1
    s_cbranch_scc1 L_dead
    s_cmp_ge_u32 s40, 107
    s_cbranch_scc1 L_ok85
    s_sleep 1
    s_branch L_sp84
L_ok85:
L_pk83:
    s_wqm_b64 exec, s[42:43]
    s_cbranch_execz L_sk86
    buffer_load_dwordx4 v[8:11], v140, s[60:63], s50 offen offset:0 sc1
L_sk86:
    s_wqm_b64 exec, s[44:45]
    s_cbranch_execz L_sk87
    buffer_load_dwordx4 v[12:15], v140, s[60:63], s50 offen offset:2048 sc1
L_sk87:
    s_wqm_b64 exec, s[46:47]
    s_cbranch_execz L_sk88
    buffer_load_dwordx4 v[16:19], v140, s[60:63], s51 offen offset:0 sc1
L_sk88:
    s_wqm_b64 exec, s[48:49]
    s_cbranch_execz L_sk89
    buffer_load_dwordx4 v[20:23], v140, s[60:63], s51 offen offset:2048 sc1
L_sk89:
    s_mov_b64 exec, -1
L_ck82:
    s_waitcnt vmcnt(0)
    v_perm_b32 v4, v10, v11, s36
    v_cmp_ne_u32 s[42:43], s37, v4
    v_perm_b32 v4, v14, v15, s36
    v_cmp_ne_u32 s[44:45], s37, v4
    v_perm_b32 v4, v18, v19, s36
    v_cmp_ne_u32 s[46:47], s37, v4
    v_perm_b32 v4, v22, v23, s36
    v_cmp_ne_u32 s[48:49], s37, v4
    s_add_u32 s64, s64, 1
    s_sub_u32 s97, s97, 64
    s_cbranch_scc1 L_dead
    s_or_b64 vcc, s[42:43], s[44:45]
    s_or_b64 vcc, vcc, s[46:47]
    s_or_b64 vcc, vcc, s[48:49]
    s_cbranch_scc1 L_ag81
    v_max3_f32 v40, v10, v14, v18
    v_max_f32 v40, v40, v22
    v_mov_b32 v41, v40
    s_nop 1
    v_permlane16_swap_b32 v40, v41
    s_nop 0
    v_max_f32 v40, v40, v41
    v_mov_b32 v41, v40
    s_nop 1
    v_permlane32_swap_b32 v40, v41
    s_nop 0
    v_max_f32 v40, v40, v41
    v_sub_f32 v10, v10, v40
    v_sub_f32 v14, v14, v40
    v_sub_f32 v18, v18, v40
    v_sub_f32 v22, v22, v40
    v_exp_f32 v10, v10
    v_exp_f32 v14, v14
    v_exp_f32 v18, v18
    v_exp_f32 v22, v22
    v_lshlrev_b32 v50, 16, v8
    v_and_b32 v51, 0xffff0000, v8
    v_lshlrev_b32 v52, 16, v9
    v_and_b32 v53, 0xffff0000, v9
    v_mul_f32 v44, v10, v11
    v_mul_f32 v45, v10, v50
    v_mul_f32 v46, v10, v51
    v_mul_f32 v47, v10, v52
    v_mul_f32 v48, v10, v53
    v_lshlrev_b32 v50, 16, v12
    v_and_b32 v51, 0xffff0000, v12
    v_lshlrev_b32 v52, 16, v13
    v_and_b32 v53, 0xffff0000, v13
    v_fmac_f32 v44, v14, v15
    v_fmac_f32 v45, v14, v50
    v_fmac_f32 v46, v14, v51
    v_fmac_f32 v47, v14, v52
    v_fmac_f32 v48, v14, v53
    v_lshlrev_b32 v50, 16, v16
    v_and_b32 v51, 0xffff0000, v16
    v_lshlrev_b32 v52, 16, v17
    v_and_b32 v53, 0xffff0000, v17
    v_fmac_f32 v44, v18, v19
    v_fmac_f32 v45, v18, v50
    v_fmac_f32 v46, v18, v51
    v_fmac_f32 v47, v18, v52
    v_fmac_f32 v48, v18, v53
    v_lshlrev_b32 v50, 16, v20
    v_and_b32 v51, 0xffff0000, v20
    v_lshlrev_b32 v52, 16, v21
    v_and_b32 v53, 0xffff0000, v21
    v_fmac_f32 v44, v22, v23
    v_fmac_f32 v45, v22, v50
    v_fmac_f32 v46, v22, v51
    v_fmac_f32 v47, v22, v52
    v_fmac_f32 v48, v22, v53
    v_mov_b32 v50, v44
    v_permlane32_swap_b32 v45, v47
    v_permlane32_swap_b32 v46, v48
    v_permlane32_swap_b32 v44, v50
    v_add_f32 v45, v45, v47
    v_add_f32 v46, v46, v48
    v_add_f32 v44, v44, v50
    v_mov_b32 v50, v44
    v_permlane16_swap_b32 v45, v46
    s_nop 0
    v_permlane16_swap_b32 v44, v50
    v_add_f32 v45, v45, v46
    v_add_f32 v44, v44, v50
    v_rcp_f32 v44, v44
    s_nop 0
    v_mul_f32 v45, v44, v45
    v_cvt_pk_bf16_f32 v50, v45, v45
    ds_write_b16 v141, v50
    s_waitcnt lgkmcnt(0)
    s_barrier
    ds_read_b128 v[72:75], v147 offset:0
    ds_read_b128 v[76:79], v147 offset:64
    ds_read_b128 v[80:83], v147 offset:128
    ds_read_b128 v[84:87], v147 offset:192
    ds_read_b64_tr_b16 v[112:113], v142 offset:32768
    ds_read_b64_tr_b16 v[114:115], v142 offset:34816
    ds_read_b64_tr_b16 v[116:117], v143 offset:32768
    ds_read_b64_tr_b16 v[118:119], v143 offset:34816
    ds_read_b64_tr_b16 v[120:121], v142 offset:49152
    ds_read_b64_tr_b16 v[122:123], v142 offset:51200
    ds_read_b64_tr_b16 v[124:125], v143 offset:49152
    ds_read_b64_tr_b16 v[126:127], v143 offset:51200
    s_waitcnt lgkmcnt(11)
    v_mfma_f32_16x16x32_bf16 v[56:59], v[72:75], v[96:99], 0
    v_mfma_f32_16x16x32_bf16 v[60:63], v[72:75], v[100:103], 0
    s_waitcnt lgkmcnt(10)
    v_mfma_f32_16x16x32_bf16 v[56:59], v[76:79], v[104:107], v[56:59]
    v_mfma_f32_16x16x32_bf16 v[60:63], v[76:79], v[108:111], v[60:63]
    s_waitcnt lgkmcnt(4)
    v_mfma_f32_16x16x32_bf16 v[56:59], v[80:83], v[112:115], v[56:59]
    v_mfma_f32_16x16x32_bf16 v[60:63], v[80:83], v[116:119], v[60:63]
    s_waitcnt lgkmcnt(0)
    v_mfma_f32_16x16x32_bf16 v[56:59], v[84:87], v[120:123], v[56:59]
    v_mfma_f32_16x16x32_bf16 v[60:63], v[84:87], v[124:127], v[60:63]
    s_nop 6
    v_mov_b32_dpp v56, v57 row_ror:8 row_mask:0xf bank_mask:0xc
    v_mov_b32_dpp v59, v58 row_ror:8 row_mask:0xf bank_mask:0x3
    v_mov_b32_dpp v60, v61 row_ror:8 row_mask:0xf bank_mask:0xc
    v_mov_b32_dpp v63, v62 row_ror:8 row_mask:0xf bank_mask:0x3
    s_mov_b32 exec_hi, 0
    v_bfi_b32 v64, v166, s4, v56
    v_bfi_b32 v65, v166, s35, v59
    v_bfi_b32 v66, v166, s10, v60
    v_bfi_b32 v67, v166, s5, v63
    buffer_store_dwordx4 v[64:67], v149, s[60:63], s55 offen sc1
    s_mov_b64 exec, -1
    s_cmp_lg_u32 s3, 0
    s_cbranch_scc1 L_fin
    s_mov_b32 s53, s2
    s_lshl_b32 s50, s53, 12
    s_add_u32 s50, s50, 4194304
    v_lshlrev_b32 v2, 4, v0
    buffer_load_dwordx4 v[8:11], v2, s[60:63], s50 offen offset:0 sc1
    buffer_load_dwordx4 v[12:15], v2, s[60:63], s50 offen offset:1024 sc1
    buffer_load_dwordx4 v[16:19], v2, s[60:63], s50 offen offset:2048 sc1
    buffer_load_dwordx4 v[20:23], v2, s[60:63], s50 offen offset:3072 sc1
    s_mov_b32 s56, s24
    s_mov_b32 s57, s25
    s_mov_b32 s58, 16384
    s_mov_b32 s59, 0x20000
    s_bfe_u32 s54, s53, 0x20003
    s_lshl_b32 s51, s54, 12
    s_lshr_b32 s54, s53, 7
    s_lshl_b32 s54, s54, 11
    s_add_u32 s51, s51, s54
    s_bfe_u32 s54, s53, 0x20005
    s_lshl_b32 s54, s54, 9
    s_add_u32 s51, s51, s54
    s_and_b32 s54, s53, 7
    s_lshl_b32 s54, s54, 6
    s_add_u32 s51, s51, s54
    v_and_b32 v3, 7, v0
    v_lshlrev_b32 v3, 1, v3
    v_and_b32 v6, 48, v0
    v_add_u32 v3, v3, v6
    s_mov_b32 s64, 0
    s_branch L_ck91
L_ag90:
L_pk92:
    s_wqm_b64 exec, s[42:43]
    s_cbranch_execz L_sk93
    buffer_load_dwordx4 v[8:11], v2, s[60:63], s50 offen offset:0 sc1
L_sk93:
    s_wqm_b64 exec, s[44:45]
    s_cbranch_execz L_sk94
    buffer_load_dwordx4 v[12:15], v2, s[60:63], s50 offen offset:1024 sc1
L_sk94:
    s_wqm_b64 exec, s[46:47]
    s_cbranch_execz L_sk95
    buffer_load_dwordx4 v[16:19], v2, s[60:63], s50 offen offset:2048 sc1
L_sk95:
    s_wqm_b64 exec, s[48:49]
    s_cbranch_execz L_sk96
    buffer_load_dwordx4 v[20:23], v2, s[60:63], s50 offen offset:3072 sc1
L_sk96:
    s_mov_b64 exec, -1
L_ck91:
    s_waitcnt vmcnt(0)
    v_perm_b32 v4, v8, v9, s36
    v_perm_b32 v5, v10, v11, s36
    v_lshl_or_b32 v4, v5, 16, v4
    v_cmp_ne_u32 s[42:43], s38, v4
    v_perm_b32 v4, v12, v13, s36
    v_perm_b32 v5, v14, v15, s36
    v_lshl_or_b32 v4, v5, 16, v4
    v_cmp_ne_u32 s[44:45], s38, v4
    v_perm_b32 v4, v16, v17, s36
    v_perm_b32 v5, v18, v19, s36
    v_lshl_or_b32 v4, v5, 16, v4
    v_cmp_ne_u32 s[46:47], s38, v4
    v_perm_b32 v4, v20, v21, s36
    v_perm_b32 v5, v22, v23, s36
    v_lshl_or_b32 v4, v5, 16, v4
    v_cmp_ne_u32 s[48:49], s38, v4
    s_add_u32 s64, s64, 1
    s_sub_u32 s97, s97, 64
    s_cbranch_scc1 L_dead
    s_or_b64 vcc, s[42:43], s[44:45]
    s_or_b64 vcc, vcc, s[46:47]
    s_or_b64 vcc, vcc, s[48:49]
    s_cbranch_scc1 L_ag90
    v_add_f32 v28, v8, v12
    v_add_f32 v36, v16, v20
    v_add_f32 v29, v9, v13
    v_add_f32 v37, v17, v21
    v_add_f32 v30, v10, v14
    v_add_f32 v38, v18, v22
    v_add_f32 v31, v11, v15
    v_add_f32 v39, v19, v23
    v_add_f32 v28, v28, v36
    v_add_f32 v29, v29, v37
    v_add_f32 v30, v30, v38
    v_add_f32 v31, v31, v39
    s_nop 0
    v_permlane32_swap_b32 v28, v30
    v_permlane32_swap_b32 v29, v31
    s_nop 0
    v_add_f32 v28, v28, v30
    v_add_f32 v29, v29, v31
    s_nop 1
    v_permlane16_swap_b32 v28, v29
    s_nop 0
    v_add_f32 v28, v28, v29
    s_nop 1
    v_add_f32_dpp v28, v28, v28 row_ror:8 row_mask:0xf bank_mask:0xf
    s_nop 1
    v_mov_b32_dpp v29, v28 quad_perm:[1,0,3,2] row_mask:0xf bank_mask:0xf
    s_mov_b32 exec_lo, 0x00550055
    s_mov_b32 exec_hi, 0x00550055
    v_cvt_pk_bf16_f32 v32, v28, v29
    buffer_store_dword v32, v3, s[56:59], s51 offen
    s_cmp_lg_u32 s2, 0
    s_cbranch_scc1 L_fin
    s_mov_b64 exec, 1
    v_mov_b32 v4, s34
    v_mov_b32 v5, 0
    buffer_store_dword v4, v5, s[60:63], 0 offen
L_fin:
L_dead:
L_end:
    s_endpgm
.section .rodata,"a"
.p2align 6
.amdhsa_kernel concat_heads__sliding_block_cached__gqa_block_cached__decode_kernel
  .amdhsa_next_free_vgpr 168
  .amdhsa_next_free_sgpr 100
  .amdhsa_accum_offset 168
  .amdhsa_group_segment_fixed_size 0
  .amdhsa_kernarg_size 104
  .amdhsa_user_sgpr_count 2
  .amdhsa_user_sgpr_kernarg_segment_ptr 1
  .amdhsa_system_sgpr_workgroup_id_x 1
.end_amdhsa_kernel
```
